```python
import torch

def _softmax(x, axis=-1):
    return torch.softmax(x, dim=axis)
def _gelu(x):
    return torch.nn.functional.gelu(x, approximate="tanh")
def _silu(x):
    return torch.nn.functional.silu(x)
def _sigmoid(x):
    return torch.sigmoid(x)
def _layernorm(x, axis=-1, eps=1e-5):
    m = x.mean(dim=axis, keepdim=True)
    v = x.var(dim=axis, keepdim=True, unbiased=False)
    return (x - m) / torch.sqrt(v + eps)
def _scatter_add(tgt, idx, src, axis=0):
    return tgt.clone().index_add_(axis, idx, src)
def _segment_sum(src, seg, n):
    out = torch.zeros((n,) + src.shape[1:], dtype=src.dtype)
    return out.index_add_(0, seg, src)
def _pad(x, pw):
    flat = tuple(v for pair in reversed(pw) for v in pair)
    return torch.nn.functional.pad(x, flat)

kernel_name = 'standalone__deepnorm__sampling'

def setup_inputs():

    _w = (lambda a: (lambda t: t.to(torch.bfloat16) if t.is_floating_point() else t)(torch.as_tensor(a)))
    B, S, D = 1024, 4, 1024
    return {
        "x": _w((lambda *s: torch.randn(*s, dtype=torch.bfloat16) * 0.05)(B, S, D)),
        "f": _w((lambda *s: torch.randn(*s, dtype=torch.bfloat16) * 0.05)(B, S, D)),
        "g": _w((lambda *s: torch.randn(*s, dtype=torch.bfloat16) * 0.05)(D) + 1.0),
        "b": _w((lambda *s: torch.randn(*s, dtype=torch.bfloat16) * 0.4)(D)),
        "alpha": _w(float(2.0)),
    }

def reference(x, f, g, b, alpha):
    return _layernorm(alpha * x + f, axis=-1) * g + b
```

```asm
; @launch grid=(256,1,1) block=(512,1,1) lds=0
.amdgcn_target "amdgcn-amd-amdhsa--gfx950"
.text
.globl standalone__deepnorm__sampling_kernel
.p2align 12
.p2align 8
.type standalone__deepnorm__sampling_kernel,@function
standalone__deepnorm__sampling_kernel:
    s_load_dwordx8 s[4:11], s[0:1], 0
    s_load_dwordx4 s[12:15], s[0:1], 32
    s_cmpk_ge_u32 s2, 256
    s_cbranch_scc1 L_end
    s_lshl_b32 s3, s2, 14
    v_lshlrev_b32 v2, 4, v0
    s_movk_i32 s16, 0xfc00
    v_and_b32 v3, s16, v2
    v_add3_u32 v1, v2, v3, s3
    v_sub_u32 v2, v2, v3
    s_waitcnt lgkmcnt(0)
    global_load_dwordx4 v[4:7], v1, s[4:5] nt
    global_load_dwordx4 v[8:11], v1, s[6:7] nt
    global_load_dwordx4 v[12:15], v1, s[4:5] offset:1024 nt
    global_load_dwordx4 v[16:19], v1, s[6:7] offset:1024 nt
    s_load_dword s17, s[12:13], 0
    global_load_dwordx4 v[36:39], v2, s[8:9]
    global_load_dwordx4 v[40:43], v2, s[8:9] offset:1024
    global_load_dwordx4 v[44:47], v2, s[10:11]
    global_load_dwordx4 v[48:51], v2, s[10:11] offset:1024
    v_xor_b32 v125, 0x402000, v1
    s_mov_b32 s16, 0xffff0000
    v_mov_b32 v116, 0xba80ba80
    v_mov_b32 v117, 0xba80ba80
    v_mov_b32 v118, 0xba80ba80
    v_mov_b32 v119, 0xba80ba80
    v_and_b32 v3, 3, v0
    v_lshlrev_b32 v3, 4, v3
    v_mov_b32 v100, 0x3f80
    v_mov_b32 v101, 0
    v_lshlrev_b64 v[110:111], v3, v[100:101]
    s_waitcnt lgkmcnt(0)
    s_lshl_b32 s18, s17, 16
    v_mov_b32 v105, 0xba800000
    v_mul_f32 v112, s18, v105
    v_lshrrev_b32 v113, 16, v112
    v_and_or_b32 v112, v112, s16, v113
    v_mov_b32 v113, v112
    v_mov_b32 v114, v112
    v_mov_b32 v115, v112
    s_and_b32 s17, s17, 0xffff
    v_mov_b32 v100, s17
    v_lshlrev_b64 v[108:109], v3, v[100:101]
    v_mov_b32 v106, 0x3a800000
    v_mov_b32 v107, 0x3727c5ac
    s_waitcnt vmcnt(6)
    v_mfma_f32_16x16x32_bf16 v[120:123], v[112:115], v[4:7], 0
    v_mfma_f32_16x16x32_bf16 v[120:123], v[116:119], v[8:11], v[120:123]
    v_mfma_f32_4x4x4_16b_bf16 v[84:87], v[108:109], v[4:5], 0
    v_mfma_f32_4x4x4_16b_bf16 v[88:91], v[108:109], v[6:7], 0
    s_nop 0
    v_mfma_f32_4x4x4_16b_bf16 v[84:87], v[110:111], v[8:9], v[84:87]
    v_mfma_f32_4x4x4_16b_bf16 v[88:91], v[110:111], v[10:11], v[88:91]
    s_waitcnt vmcnt(4)
    v_mfma_f32_16x16x32_bf16 v[120:123], v[112:115], v[12:15], v[120:123]
    v_mfma_f32_16x16x32_bf16 v[120:123], v[116:119], v[16:19], v[120:123]
    s_nop 7
    v_add_f32_dpp v100, v120, v120 quad_perm:[1,0,3,2] row_mask:0xf bank_mask:0xf
    v_mfma_f32_4x4x4_16b_bf16 v[92:95], v[108:109], v[12:13], 0
    v_mfma_f32_4x4x4_16b_bf16 v[96:99], v[108:109], v[14:15], 0
    v_add_f32_dpp v100, v100, v100 quad_perm:[2,3,0,1] row_mask:0xf bank_mask:0xf
    v_mfma_f32_4x4x4_16b_bf16 v[92:95], v[110:111], v[16:17], v[92:95]
    v_mfma_f32_4x4x4_16b_bf16 v[96:99], v[110:111], v[18:19], v[96:99]
    v_add_f32_dpp v100, v100, v100 row_half_mirror row_mask:0xf bank_mask:0xf
    s_nop 1
    v_add_f32_dpp v100, v100, v100 row_mirror row_mask:0xf bank_mask:0xf
    v_pk_add_f32 v[84:85], v[84:85], v[100:101] op_sel_hi:[1,0]
    v_pk_add_f32 v[86:87], v[86:87], v[100:101] op_sel_hi:[1,0]
    v_pk_add_f32 v[88:89], v[88:89], v[100:101] op_sel_hi:[1,0]
    v_pk_add_f32 v[90:91], v[90:91], v[100:101] op_sel_hi:[1,0]
    v_pk_add_f32 v[92:93], v[92:93], v[100:101] op_sel_hi:[1,0]
    v_pk_add_f32 v[94:95], v[94:95], v[100:101] op_sel_hi:[1,0]
    v_pk_add_f32 v[96:97], v[96:97], v[100:101] op_sel_hi:[1,0]
    v_pk_add_f32 v[98:99], v[98:99], v[100:101] op_sel_hi:[1,0]
    v_pk_mul_f32 v[100:101], v[84:85], v[84:85]
    v_pk_fma_f32 v[100:101], v[86:87], v[86:87], v[100:101]
    v_pk_fma_f32 v[100:101], v[88:89], v[88:89], v[100:101]
    v_pk_fma_f32 v[100:101], v[90:91], v[90:91], v[100:101]
    v_pk_fma_f32 v[100:101], v[92:93], v[92:93], v[100:101]
    v_pk_fma_f32 v[100:101], v[94:95], v[94:95], v[100:101]
    v_pk_fma_f32 v[100:101], v[96:97], v[96:97], v[100:101]
    v_pk_fma_f32 v[100:101], v[98:99], v[98:99], v[100:101]
    v_add_f32 v100, v100, v101
    global_load_dwordx4 v[20:23], v125, s[4:5] nt
    global_load_dwordx4 v[24:27], v125, s[6:7] nt
    global_load_dwordx4 v[28:31], v125, s[4:5] offset:1024 nt
    global_load_dwordx4 v[32:35], v125, s[6:7] offset:1024 nt
    s_waitcnt vmcnt(4)
    v_lshlrev_b32 v52, 16, v36
    v_and_b32 v53, s16, v36
    v_lshlrev_b32 v54, 16, v37
    v_and_b32 v55, s16, v37
    v_lshlrev_b32 v56, 16, v38
    v_and_b32 v57, s16, v38
    v_lshlrev_b32 v58, 16, v39
    v_and_b32 v59, s16, v39
    v_lshlrev_b32 v60, 16, v40
    v_and_b32 v61, s16, v40
    v_lshlrev_b32 v62, 16, v41
    v_and_b32 v63, s16, v41
    v_lshlrev_b32 v64, 16, v42
    v_and_b32 v65, s16, v42
    v_lshlrev_b32 v66, 16, v43
    v_and_b32 v67, s16, v43
    v_lshlrev_b32 v68, 16, v44
    v_and_b32 v69, s16, v44
    v_lshlrev_b32 v70, 16, v45
    v_and_b32 v71, s16, v45
    v_lshlrev_b32 v72, 16, v46
    v_and_b32 v73, s16, v46
    v_lshlrev_b32 v74, 16, v47
    v_and_b32 v75, s16, v47
    v_lshlrev_b32 v76, 16, v48
    v_and_b32 v77, s16, v48
    v_lshlrev_b32 v78, 16, v49
    v_and_b32 v79, s16, v49
    v_lshlrev_b32 v80, 16, v50
    v_and_b32 v81, s16, v50
    v_lshlrev_b32 v82, 16, v51
    v_and_b32 v83, s16, v51
    v_pk_mul_f32 v[84:85], v[84:85], v[52:53]
    v_pk_mul_f32 v[86:87], v[86:87], v[54:55]
    v_add_f32_dpp v100, v100, v100 quad_perm:[1,0,3,2] row_mask:0xf bank_mask:0xf
    v_pk_mul_f32 v[88:89], v[88:89], v[56:57]
    v_pk_mul_f32 v[90:91], v[90:91], v[58:59]
    v_add_f32_dpp v100, v100, v100 quad_perm:[2,3,0,1] row_mask:0xf bank_mask:0xf
    v_pk_mul_f32 v[92:93], v[92:93], v[60:61]
    v_pk_mul_f32 v[94:95], v[94:95], v[62:63]
    v_add_f32_dpp v100, v100, v100 row_half_mirror row_mask:0xf bank_mask:0xf
    v_pk_mul_f32 v[96:97], v[96:97], v[64:65]
    v_pk_mul_f32 v[98:99], v[98:99], v[66:67]
    v_add_f32_dpp v100, v100, v100 row_mirror row_mask:0xf bank_mask:0xf
    s_nop 0
    v_readlane_b32 s20, v100, 0
    v_readlane_b32 s21, v100, 16
    v_readlane_b32 s22, v100, 32
    v_readlane_b32 s23, v100, 48
    v_fma_f32 v100, s20, v106, v107
    v_fmac_f32 v100, s21, v106
    v_fmac_f32 v100, s22, v106
    v_fmac_f32 v100, s23, v106
    v_rsq_f32 v100, v100
    s_nop 0
    v_pk_fma_f32 v[84:85], v[84:85], v[100:101], v[68:69] op_sel_hi:[1,0,1]
    v_cvt_pk_bf16_f32 v8, v84, v85
    v_pk_fma_f32 v[86:87], v[86:87], v[100:101], v[70:71] op_sel_hi:[1,0,1]
    v_cvt_pk_bf16_f32 v9, v86, v87
    v_pk_fma_f32 v[88:89], v[88:89], v[100:101], v[72:73] op_sel_hi:[1,0,1]
    v_cvt_pk_bf16_f32 v10, v88, v89
    v_pk_fma_f32 v[90:91], v[90:91], v[100:101], v[74:75] op_sel_hi:[1,0,1]
    v_cvt_pk_bf16_f32 v11, v90, v91
    global_store_dwordx4 v1, v[8:11], s[14:15]
    v_pk_fma_f32 v[92:93], v[92:93], v[100:101], v[76:77] op_sel_hi:[1,0,1]
    v_cvt_pk_bf16_f32 v12, v92, v93
    v_pk_fma_f32 v[94:95], v[94:95], v[100:101], v[78:79] op_sel_hi:[1,0,1]
    v_cvt_pk_bf16_f32 v13, v94, v95
    v_pk_fma_f32 v[96:97], v[96:97], v[100:101], v[80:81] op_sel_hi:[1,0,1]
    v_cvt_pk_bf16_f32 v14, v96, v97
    v_pk_fma_f32 v[98:99], v[98:99], v[100:101], v[82:83] op_sel_hi:[1,0,1]
    v_cvt_pk_bf16_f32 v15, v98, v99
    global_store_dwordx4 v1, v[12:15], s[14:15] offset:1024
    s_waitcnt vmcnt(5)
    v_mfma_f32_16x16x32_bf16 v[120:123], v[112:115], v[20:23], 0
    v_mfma_f32_4x4x4_16b_bf16 v[84:87], v[108:109], v[20:21], 0
    v_mfma_f32_4x4x4_16b_bf16 v[88:91], v[108:109], v[22:23], 0
    s_waitcnt vmcnt(4)
    v_mfma_f32_16x16x32_bf16 v[120:123], v[116:119], v[24:27], v[120:123]
    v_mfma_f32_4x4x4_16b_bf16 v[84:87], v[110:111], v[24:25], v[84:87]
    v_mfma_f32_4x4x4_16b_bf16 v[88:91], v[110:111], v[26:27], v[88:91]
    s_waitcnt vmcnt(3)
    v_mfma_f32_16x16x32_bf16 v[120:123], v[112:115], v[28:31], v[120:123]
    v_mfma_f32_4x4x4_16b_bf16 v[92:95], v[108:109], v[28:29], 0
    v_mfma_f32_4x4x4_16b_bf16 v[96:99], v[108:109], v[30:31], 0
    s_waitcnt vmcnt(2)
    v_mfma_f32_16x16x32_bf16 v[120:123], v[116:119], v[32:35], v[120:123]
    s_nop 7
    v_add_f32_dpp v100, v120, v120 quad_perm:[1,0,3,2] row_mask:0xf bank_mask:0xf
    v_mfma_f32_4x4x4_16b_bf16 v[92:95], v[110:111], v[32:33], v[92:95]
    v_mfma_f32_4x4x4_16b_bf16 v[96:99], v[110:111], v[34:35], v[96:99]
    v_add_f32_dpp v100, v100, v100 quad_perm:[2,3,0,1] row_mask:0xf bank_mask:0xf
    s_nop 1
    v_add_f32_dpp v100, v100, v100 row_half_mirror row_mask:0xf bank_mask:0xf
    s_nop 1
    v_add_f32_dpp v100, v100, v100 row_mirror row_mask:0xf bank_mask:0xf
    v_pk_add_f32 v[84:85], v[84:85], v[100:101] op_sel_hi:[1,0]
    v_pk_add_f32 v[86:87], v[86:87], v[100:101] op_sel_hi:[1,0]
    v_pk_add_f32 v[88:89], v[88:89], v[100:101] op_sel_hi:[1,0]
    v_pk_add_f32 v[90:91], v[90:91], v[100:101] op_sel_hi:[1,0]
    v_pk_add_f32 v[92:93], v[92:93], v[100:101] op_sel_hi:[1,0]
    v_pk_add_f32 v[94:95], v[94:95], v[100:101] op_sel_hi:[1,0]
    v_pk_add_f32 v[96:97], v[96:97], v[100:101] op_sel_hi:[1,0]
    v_pk_add_f32 v[98:99], v[98:99], v[100:101] op_sel_hi:[1,0]
    v_pk_mul_f32 v[100:101], v[84:85], v[84:85]
    v_pk_fma_f32 v[100:101], v[86:87], v[86:87], v[100:101]
    v_pk_fma_f32 v[100:101], v[88:89], v[88:89], v[100:101]
    v_pk_fma_f32 v[100:101], v[90:91], v[90:91], v[100:101]
    v_pk_fma_f32 v[100:101], v[92:93], v[92:93], v[100:101]
    v_pk_fma_f32 v[100:101], v[94:95], v[94:95], v[100:101]
    v_pk_fma_f32 v[100:101], v[96:97], v[96:97], v[100:101]
    v_pk_fma_f32 v[100:101], v[98:99], v[98:99], v[100:101]
    v_add_f32 v100, v100, v101
    v_pk_mul_f32 v[84:85], v[84:85], v[52:53]
    v_pk_mul_f32 v[86:87], v[86:87], v[54:55]
    v_add_f32_dpp v100, v100, v100 quad_perm:[1,0,3,2] row_mask:0xf bank_mask:0xf
    v_pk_mul_f32 v[88:89], v[88:89], v[56:57]
    v_pk_mul_f32 v[90:91], v[90:91], v[58:59]
    v_add_f32_dpp v100, v100, v100 quad_perm:[2,3,0,1] row_mask:0xf bank_mask:0xf
    v_pk_mul_f32 v[92:93], v[92:93], v[60:61]
    v_pk_mul_f32 v[94:95], v[94:95], v[62:63]
    v_add_f32_dpp v100, v100, v100 row_half_mirror row_mask:0xf bank_mask:0xf
    v_pk_mul_f32 v[96:97], v[96:97], v[64:65]
    v_pk_mul_f32 v[98:99], v[98:99], v[66:67]
    v_add_f32_dpp v100, v100, v100 row_mirror row_mask:0xf bank_mask:0xf
    s_nop 0
    v_readlane_b32 s20, v100, 0
    v_readlane_b32 s21, v100, 16
    v_readlane_b32 s22, v100, 32
    v_readlane_b32 s23, v100, 48
    v_fma_f32 v100, s20, v106, v107
    v_fmac_f32 v100, s21, v106
    v_fmac_f32 v100, s22, v106
    v_fmac_f32 v100, s23, v106
    v_rsq_f32 v100, v100
    s_nop 0
    v_pk_fma_f32 v[84:85], v[84:85], v[100:101], v[68:69] op_sel_hi:[1,0,1]
    v_cvt_pk_bf16_f32 v24, v84, v85
    v_pk_fma_f32 v[86:87], v[86:87], v[100:101], v[70:71] op_sel_hi:[1,0,1]
    v_cvt_pk_bf16_f32 v25, v86, v87
    v_pk_fma_f32 v[88:89], v[88:89], v[100:101], v[72:73] op_sel_hi:[1,0,1]
    v_cvt_pk_bf16_f32 v26, v88, v89
    v_pk_fma_f32 v[90:91], v[90:91], v[100:101], v[74:75] op_sel_hi:[1,0,1]
    v_cvt_pk_bf16_f32 v27, v90, v91
    global_store_dwordx4 v125, v[24:27], s[14:15]
    v_pk_fma_f32 v[92:93], v[92:93], v[100:101], v[76:77] op_sel_hi:[1,0,1]
    v_cvt_pk_bf16_f32 v28, v92, v93
    v_pk_fma_f32 v[94:95], v[94:95], v[100:101], v[78:79] op_sel_hi:[1,0,1]
    v_cvt_pk_bf16_f32 v29, v94, v95
    v_pk_fma_f32 v[96:97], v[96:97], v[100:101], v[80:81] op_sel_hi:[1,0,1]
    v_cvt_pk_bf16_f32 v30, v96, v97
    v_pk_fma_f32 v[98:99], v[98:99], v[100:101], v[82:83] op_sel_hi:[1,0,1]
    v_cvt_pk_bf16_f32 v31, v98, v99
    global_store_dwordx4 v125, v[28:31], s[14:15] offset:1024
L_end:
    s_endpgm
.section .rodata,"a"
.p2align 6
.amdhsa_kernel standalone__deepnorm__sampling_kernel
  .amdhsa_next_free_vgpr 126
  .amdhsa_next_free_sgpr 24
  .amdhsa_accum_offset 128
  .amdhsa_group_segment_fixed_size 0
  .amdhsa_kernarg_size 64
  .amdhsa_user_sgpr_count 2
  .amdhsa_user_sgpr_kernarg_segment_ptr 1
  .amdhsa_system_sgpr_workgroup_id_x 1
  .amdhsa_float_denorm_mode_32 3
.end_amdhsa_kernel
```
